```python
import torch

def _softmax(x, axis=-1):
    return torch.softmax(x, dim=axis)
def _gelu(x):
    return torch.nn.functional.gelu(x, approximate="tanh")
def _silu(x):
    return torch.nn.functional.silu(x)
def _sigmoid(x):
    return torch.sigmoid(x)
def _layernorm(x, axis=-1, eps=1e-5):
    m = x.mean(dim=axis, keepdim=True)
    v = x.var(dim=axis, keepdim=True, unbiased=False)
    return (x - m) / torch.sqrt(v + eps)
def _scatter_add(tgt, idx, src, axis=0):
    return tgt.clone().index_add_(axis, idx, src)
def _segment_sum(src, seg, n):
    out = torch.zeros((n,) + src.shape[1:], dtype=src.dtype)
    return out.index_add_(0, seg, src)
def _pad(x, pw):
    flat = tuple(v for pair in reversed(pw) for v in pair)
    return torch.nn.functional.pad(x, flat)

kernel_name = 'standalone__linear_kernel_rfa__decode'

def setup_inputs():

    _w = (lambda a: (lambda t: t.to(torch.bfloat16) if t.is_floating_point() else t)(torch.as_tensor(a)))
    B, H, Sq, Sk, D, M = 1, 32, 1, 32768, 128, 8
    return {
        "q": _w((lambda *s: torch.randn(*s, dtype=torch.bfloat16) * 0.05)(B, H, Sq, D)),
        "k": _w((lambda *s: torch.randn(*s, dtype=torch.bfloat16) * 0.4)(B, H, Sk, D)),
        "v": _w((lambda *s: torch.randn(*s, dtype=torch.bfloat16) * 0.4)(B, H, Sk, D)),
        "omega": _w((lambda *s: torch.randn(*s, dtype=torch.bfloat16) * 0.8)(M, D)),
    }

def reference(q, k, v, omega):
    d = q.shape[-1]
    m = omega.shape[0]
    scale = float(d) ** -0.25
    qs = q * scale
    ks = k * scale
    q_proj = torch.einsum("bhsd,md->bhsm", qs, omega)
    k_proj = torch.einsum("bhsd,md->bhsm", ks, omega)
    q_sq = 0.5 * torch.einsum("bhsd,bhsd->bhs", qs, qs)[..., None]
    k_sq = 0.5 * torch.einsum("bhsd,bhsd->bhs", ks, ks)[..., None]
    inv_sqrt_m = float(m) ** -0.5
    phi_q = torch.exp(q_proj - q_sq) * inv_sqrt_m + 1e-6
    phi_k = torch.exp(k_proj - k_sq) * inv_sqrt_m + 1e-6
    kv = torch.einsum("bhsm,bhsd->bhmd", phi_k, v)
    z  = torch.einsum("bhsm->bhm", phi_k)
    num = torch.einsum("bhqm,bhmd->bhqd", phi_q, kv)
    den = torch.einsum("bhqm,bhm->bhq", phi_q, z)[..., None] + 1e-6
    return num / den
```

```asm
; @launch grid=(256,1,1) block=(128,1,1) lds=6464
.amdgcn_target "amdgcn-amd-amdhsa--gfx950"
.text
.globl standalone__linear_kernel_rfa__decode_kernel
.p2align 8
.type standalone__linear_kernel_rfa__decode_kernel,@function
standalone__linear_kernel_rfa__decode_kernel:
  s_cmp_ge_u32 s2, 256
  s_cbranch_scc1 L_done
  s_load_dwordx8 s[40:47], s[0:1], 0
  s_load_dwordx4 s[48:51], s[0:1], 32
  s_load_dwordx2 s[52:53], s[0:1], 48
  v_lshrrev_b32 v6, 6, v0
  v_and_b32 v1, 63, v0
  v_readfirstlane_b32 s3, v6
  s_getpc_b64 s[36:37]
L_pc:
  v_lshlrev_b32 v7, 6, v1
  v_min_u32 v7, L_last-L_pc, v7
  global_load_dword v14, v7, s[36:37]
  v_and_b32 v7, 15, v1
  v_lshrrev_b32 v8, 4, v1
  v_lshlrev_b32 v2, 8, v7
  v_lshl_add_u32 v2, v8, 4, v2
  v_lshlrev_b32 v3, 4, v1
  v_lshlrev_b32 v10, 4, v8
  s_lshr_b32 s27, s2, 3
  s_add_u32 s15, s2, s27
  s_and_b32 s15, s15, 7
  s_lshl_b32 s16, s15, 8
  s_lshl_b32 s13, s3, 1
  s_add_u32 s16, s16, s13
  s_or_b32 s23, s15, s3
  s_lshl_b32 s29, s27, 23
  s_lshl_b32 s28, s27, 8
  s_lshl_b32 s22, s16, 12
  v_add_u32 v4, s22, v2
  v_add_u32 v5, s22, v3
  s_mov_b32 s6, 8388608
  s_mov_b32 s7, 0x00020000
  s_mov_b32 s10, 8388608
  s_mov_b32 s11, 0x00020000
  s_waitcnt lgkmcnt(0)
  s_add_u32 s4, s42, s29
  s_addc_u32 s5, s43, 0
  buffer_load_dwordx4 v[84:87], v4, s[4:7], 0 offen offset:0 nt
  buffer_load_dwordx4 v[88:91], v4, s[4:7], 0 offen offset:64 nt
  buffer_load_dwordx4 v[92:95], v4, s[4:7], 0 offen offset:128 nt
  buffer_load_dwordx4 v[96:99], v4, s[4:7], 0 offen offset:192 nt
  s_add_u32 s8, s44, s29
  s_addc_u32 s9, s45, 0
  s_add_u32 s40, s40, s28
  s_addc_u32 s41, s41, 0
  global_load_dwordx4 v[60:63], v3, s[46:47]
  global_load_dwordx4 v[64:67], v3, s[46:47] offset:1024
  global_load_dwordx4 v[20:23], v10, s[40:41] offset:0
  global_load_dwordx4 v[24:27], v10, s[40:41] offset:64
  global_load_dwordx4 v[76:79], v10, s[40:41] offset:128
  global_load_dwordx4 v[80:83], v10, s[40:41] offset:192
  buffer_load_dwordx4 v[100:103], v5, s[8:11], 0 offen offset:0 nt
  buffer_load_dwordx4 v[104:107], v5, s[8:11], 0 offen offset:1024 nt
  buffer_load_dwordx4 v[108:111], v5, s[8:11], 0 offen offset:2048 nt
  buffer_load_dwordx4 v[112:115], v5, s[8:11], 0 offen offset:3072 nt
  s_mov_b32 s32, s16
  s_add_u32 s16, s16, 1
  v_add_u32 v4, 4096, v4
  v_add_u32 v5, 4096, v5
  s_mov_b32 s33, s16
  buffer_load_dwordx4 v[116:119], v4, s[4:7], 0 offen offset:0 nt
  buffer_load_dwordx4 v[120:123], v4, s[4:7], 0 offen offset:64 nt
  buffer_load_dwordx4 v[124:127], v4, s[4:7], 0 offen offset:128 nt
  buffer_load_dwordx4 v[128:131], v4, s[4:7], 0 offen offset:192 nt
  buffer_load_dwordx4 v[132:135], v5, s[8:11], 0 offen offset:0 nt
  buffer_load_dwordx4 v[136:139], v5, s[8:11], 0 offen offset:1024 nt
  buffer_load_dwordx4 v[140:143], v5, s[8:11], 0 offen offset:2048 nt
  buffer_load_dwordx4 v[144:147], v5, s[8:11], 0 offen offset:3072 nt
  s_add_u32 s16, s16, 3
  s_mov_b32 s17, 120
  s_mov_b32 s18, 0x10000
  s_mov_b32 s19, 0
  s_add_u32 s54, s52, s28
  s_addc_u32 s55, s53, 0
  s_add_u32 s54, s54, 0x40000
  s_addc_u32 s55, s55, 0
  s_lshl_b32 s26, s27, 2
  s_add_u32 s24, s50, s26
  s_addc_u32 s25, s51, 0
  s_cmp_lg_u32 s23, 0
  s_cselect_b32 s38, 0, 1
  s_cselect_b32 s20, 4, 118
  s_mov_b32 s30, 0x3edb9ada
  s_mov_b32 s31, 0xffff0000
  v_and_b32 v7, 15, v1
  v_lshrrev_b32 v8, 4, v1
  v_lshlrev_b32 v6, 2, v8
  v_sub_u32 v6, v7, v6
  v_mov_b32 v9, 0xbd8293ee
  v_cmp_eq_u32 vcc, 0, v6
  s_nop 1
  v_cndmask_b32 v32, 0, v9, vcc
  v_cmp_eq_u32 vcc, 1, v6
  s_nop 1
  v_cndmask_b32 v33, 0, v9, vcc
  v_cmp_eq_u32 vcc, 2, v6
  s_nop 1
  v_cndmask_b32 v34, 0, v9, vcc
  v_cmp_eq_u32 vcc, 3, v6
  s_nop 1
  v_cndmask_b32 v35, 0, v9, vcc
  v_mov_b32 v9, 0x0100
  v_mov_b32 v10, 0x0302
  v_cmp_gt_u32 vcc, 8, v7
  s_nop 1
  v_cndmask_b32 v9, v10, v9, vcc
  v_or_b32 v10, 0x0c0c0000, v9
  v_lshlrev_b32 v9, 16, v9
  v_or_b32 v9, 0x0c0c, v9
  v_and_b32 v6, 1, v7
  v_cmp_eq_u32 vcc, 1, v6
  s_nop 1
  v_cndmask_b32 v9, v10, v9, vcc
  v_bfe_u32 v6, v7, 1, 2
  v_mov_b32 v10, 0x0c0c0c0c
  v_cmp_eq_u32 vcc, 0, v6
  s_nop 1
  v_cndmask_b32 v36, v10, v9, vcc
  v_cmp_eq_u32 vcc, 1, v6
  s_nop 1
  v_cndmask_b32 v37, v10, v9, vcc
  v_cmp_eq_u32 vcc, 2, v6
  s_nop 1
  v_cndmask_b32 v38, v10, v9, vcc
  v_cmp_eq_u32 vcc, 3, v6
  s_nop 1
  v_cndmask_b32 v39, v10, v9, vcc
  v_mov_b32 v40, 0x3f803f80
  v_mov_b32 v68, 0
  v_mov_b32 v72, 0
  v_mov_b32 v41, 0x3f803f80
  v_mov_b32 v69, 0
  v_mov_b32 v73, 0
  v_mov_b32 v42, 0x3f803f80
  v_mov_b32 v70, 0
  v_mov_b32 v74, 0
  v_mov_b32 v43, 0x3f803f80
  v_mov_b32 v71, 0
  v_mov_b32 v75, 0
  s_lshl_b32 s26, s3, 10
  v_add_u32 v15, s26, v3
  v_lshrrev_b32 v6, 5, v1
  s_lshl_b32 s26, s3, 3
  s_add_u32 s26, s26, 2048
  v_lshl_add_u32 v16, v6, 2, s26
  v_lshrrev_b32 v6, 2, v1
  v_bfe_u32 v7, v1, 1, 1
  v_lshl_add_u32 v6, v7, 4, v6
  v_lshlrev_b32 v6, 4, v6
  v_and_b32 v7, 1, v1
  v_lshl_add_u32 v17, v7, 3, v6
  s_mul_i32 s26, s3, 2176
  s_add_u32 s26, s26, 2112
  v_lshrrev_b32 v6, 4, v1
  v_mul_u32_u24 v6, 272, v6
  v_and_b32 v7, 15, v1
  v_lshl_add_u32 v6, v7, 4, v6
  v_add_u32 v6, s26, v6
  v_and_b32 v7, 7, v1
  v_mul_u32_u24 v7, 272, v7
  v_lshrrev_b32 v8, 4, v1
  v_lshl_add_u32 v7, v8, 4, v7
  v_add_u32 v7, s26, v7
  s_waitcnt vmcnt(12)
  ds_write_b128 v6, v[60:63]
  ds_write_b128 v6, v[64:67] offset:1088
  s_waitcnt lgkmcnt(0)
  ds_read_b128 v[44:47], v7 offset:0
  ds_read_b128 v[48:51], v7 offset:64
  ds_read_b128 v[52:55], v7 offset:128
  ds_read_b128 v[56:59], v7 offset:192
  s_waitcnt lgkmcnt(0)
  v_mfma_f32_16x16x32_bf16 v[60:63], v[44:47], v[20:23], 0
  v_mfma_f32_16x16x32_bf16 v[64:67], v[20:23], v[20:23], 0
  v_mfma_f32_16x16x32_bf16 v[60:63], v[48:51], v[24:27], v[60:63]
  v_mfma_f32_16x16x32_bf16 v[64:67], v[24:27], v[24:27], v[64:67]
  v_mfma_f32_16x16x32_bf16 v[60:63], v[52:55], v[76:79], v[60:63]
  v_mfma_f32_16x16x32_bf16 v[64:67], v[76:79], v[76:79], v[64:67]
  v_mfma_f32_16x16x32_bf16 v[60:63], v[56:59], v[80:83], v[60:63]
  v_mfma_f32_16x16x32_bf16 v[64:67], v[80:83], v[80:83], v[64:67]
  s_nop 7
  v_mul_f32 v9, v64, v32
  v_fma_f32 v9, v65, v33, v9
  v_fma_f32 v9, v66, v34, v9
  v_fma_f32 v9, v67, v35, v9
  v_mov_b32 v6, v9
  s_nop 1
  v_permlane32_swap_b32 v9, v6
  v_add_f32 v9, v9, v6
  v_mov_b32 v6, v9
  s_nop 1
  v_permlane16_swap_b32 v9, v6
  v_add_f32 v9, v9, v6
  v_fma_f32 v20, v60, s30, v9
  v_fma_f32 v21, v61, s30, v9
  v_fma_f32 v22, v62, s30, v9
  v_fma_f32 v23, v63, s30, v9
  v_exp_f32 v20, v20
  v_exp_f32 v21, v21
  v_exp_f32 v22, v22
  v_exp_f32 v23, v23
  v_mov_b32 v6, 0x3eb504f3
  v_mov_b32 v7, 0x358637bd
  v_fma_f32 v20, v20, v6, v7
  v_fma_f32 v21, v21, v6, v7
  v_fma_f32 v22, v22, v6, v7
  v_fma_f32 v23, v23, v6, v7
  v_add_f32 v11, v20, v21
  v_add_f32 v11, v11, v22
  v_add_f32 v11, v11, v23
  v_mul_f32 v11, v11, v7
  v_mul_f32 v28, v20, v6
  v_mul_f32 v29, v21, v6
  v_mul_f32 v30, v22, v6
  v_mul_f32 v31, v23, v6
L_loop:
  s_cmp_ge_u32 s32, 2048
  s_cbranch_scc1 L_epi
  s_waitcnt vmcnt(12)
  v_mfma_f32_16x16x32_bf16 v[60:63], v[44:47], v[84:87], 0
  v_mfma_f32_16x16x32_bf16 v[64:67], v[84:87], v[84:87], 0
  v_mfma_f32_16x16x32_bf16 v[60:63], v[48:51], v[88:91], v[60:63]
  v_mfma_f32_16x16x32_bf16 v[64:67], v[88:91], v[88:91], v[64:67]
  v_mfma_f32_16x16x32_bf16 v[60:63], v[52:55], v[92:95], v[60:63]
  v_mfma_f32_16x16x32_bf16 v[64:67], v[92:95], v[92:95], v[64:67]
  v_mfma_f32_16x16x32_bf16 v[60:63], v[56:59], v[96:99], v[60:63]
  v_mfma_f32_16x16x32_bf16 v[64:67], v[96:99], v[96:99], v[64:67]
  s_waitcnt lgkmcnt(0)
  s_and_b32 s13, s18, 7
  s_lshl_b32 s13, s13, 8
  s_lshr_b32 s14, s18, 3
  s_add_u32 s13, s13, s14
  s_add_u32 s13, s13, 244
  s_cmp_ge_u32 s18, 96
  s_cselect_b32 s13, 0x10000, s13
  s_cmp_gt_i32 s17, 0
  s_cselect_b32 s32, s16, s13
  s_lshl_b32 s22, s32, 12
  v_add_u32 v4, s22, v2
  v_add_u32 v5, s22, v3
  buffer_load_dwordx4 v[84:87], v4, s[4:7], 0 offen offset:0 nt
  buffer_load_dwordx4 v[88:91], v4, s[4:7], 0 offen offset:64 nt
  buffer_load_dwordx4 v[92:95], v4, s[4:7], 0 offen offset:128 nt
  buffer_load_dwordx4 v[96:99], v4, s[4:7], 0 offen offset:192 nt
  s_add_u32 s16, s16, 1
  s_cmp_gt_i32 s17, 1
  s_cbranch_scc1 L_na0
  s_cmp_ge_u32 s32, 2048
  s_cbranch_scc1 L_na0
  s_or_b32 s26, s19, s38
  s_cbranch_scc0 L_na0
  s_mov_b32 s18, 1
  s_atomic_add s18, s[54:55], 0x0 glc
L_na0:
  s_cmp_eq_u32 s17, s20
  s_cbranch_scc1 L_event
L_evret:
  s_sub_u32 s17, s17, 1
  v_mul_f32 v9, v64, v32
  v_fma_f32 v9, v65, v33, v9
  v_fma_f32 v9, v66, v34, v9
  v_fma_f32 v9, v67, v35, v9
  v_mov_b32 v6, v9
  s_nop 1
  v_permlane32_swap_b32 v9, v6
  v_add_f32 v9, v9, v6
  v_mov_b32 v6, v9
  s_nop 1
  v_permlane16_swap_b32 v9, v6
  v_add_f32 v9, v9, v6
  v_fma_f32 v20, v60, s30, v9
  v_fma_f32 v21, v61, s30, v9
  v_fma_f32 v22, v62, s30, v9
  v_fma_f32 v23, v63, s30, v9
  v_exp_f32 v20, v20
  v_exp_f32 v21, v21
  v_exp_f32 v22, v22
  v_exp_f32 v23, v23
  v_fma_f32 v10, v20, v28, v11
  v_fma_f32 v10, v21, v29, v10
  v_fma_f32 v10, v22, v30, v10
  v_fma_f32 v10, v23, v31, v10
  v_mov_b32 v6, v10
  s_nop 1
  v_permlane16_swap_b32 v10, v6
  v_add_f32 v10, v10, v6
  v_cvt_pk_bf16_f32 v6, v10, v10
  v_and_b32 v6, s31, v6
  v_sub_f32 v6, v10, v6
  v_cvt_pk_bf16_f32 v12, v10, v6
  v_mov_b32 v13, v12
  s_nop 0
  v_mov_b32_dpp v13, v12 row_shl:1 row_mask:0x2 bank_mask:0xf
  v_mov_b32_dpp v13, v12 row_shl:2 row_mask:0x4 bank_mask:0xf
  v_mov_b32_dpp v13, v12 row_shl:3 row_mask:0x8 bank_mask:0xf
  s_nop 1
  v_mov_b32_dpp v24, v13 row_newbcast:0 row_mask:0xf bank_mask:0xf
  v_mov_b32_dpp v25, v13 row_newbcast:4 row_mask:0xf bank_mask:0xf
  v_mov_b32_dpp v26, v13 row_newbcast:8 row_mask:0xf bank_mask:0xf
  v_mov_b32_dpp v27, v13 row_newbcast:12 row_mask:0xf bank_mask:0xf
  v_perm_b32 v76, v24, v24, v36
  v_perm_b32 v77, v24, v24, v37
  v_perm_b32 v78, v24, v24, v38
  v_perm_b32 v79, v24, v24, v39
  v_perm_b32 v80, v25, v25, v36
  v_perm_b32 v81, v25, v25, v37
  v_perm_b32 v82, v25, v25, v38
  v_perm_b32 v83, v25, v25, v39
  s_waitcnt vmcnt(12)
  v_mfma_f32_16x16x32_bf16 v[68:71], v[76:79], v[100:103], v[68:71]
  v_mfma_f32_16x16x32_bf16 v[72:75], v[76:79], v[40:43], v[72:75]
  v_perm_b32 v76, v26, v26, v36
  v_perm_b32 v77, v26, v26, v37
  v_perm_b32 v78, v26, v26, v38
  v_perm_b32 v79, v26, v26, v39
  v_mfma_f32_16x16x32_bf16 v[68:71], v[80:83], v[104:107], v[68:71]
  v_mfma_f32_16x16x32_bf16 v[72:75], v[80:83], v[40:43], v[72:75]
  v_perm_b32 v80, v27, v27, v36
  v_perm_b32 v81, v27, v27, v37
  v_perm_b32 v82, v27, v27, v38
  v_perm_b32 v83, v27, v27, v39
  v_mfma_f32_16x16x32_bf16 v[68:71], v[76:79], v[108:111], v[68:71]
  v_mfma_f32_16x16x32_bf16 v[72:75], v[76:79], v[40:43], v[72:75]
  s_nop 0
  v_mfma_f32_16x16x32_bf16 v[68:71], v[80:83], v[112:115], v[68:71]
  v_mfma_f32_16x16x32_bf16 v[72:75], v[80:83], v[40:43], v[72:75]
  buffer_load_dwordx4 v[100:103], v5, s[8:11], 0 offen offset:0 nt
  buffer_load_dwordx4 v[104:107], v5, s[8:11], 0 offen offset:1024 nt
  buffer_load_dwordx4 v[108:111], v5, s[8:11], 0 offen offset:2048 nt
  buffer_load_dwordx4 v[112:115], v5, s[8:11], 0 offen offset:3072 nt
  s_cmp_ge_u32 s33, 2048
  s_cbranch_scc1 L_epi
  s_waitcnt vmcnt(12)
  v_mfma_f32_16x16x32_bf16 v[60:63], v[44:47], v[116:119], 0
  v_mfma_f32_16x16x32_bf16 v[64:67], v[116:119], v[116:119], 0
  v_mfma_f32_16x16x32_bf16 v[60:63], v[48:51], v[120:123], v[60:63]
  v_mfma_f32_16x16x32_bf16 v[64:67], v[120:123], v[120:123], v[64:67]
  v_mfma_f32_16x16x32_bf16 v[60:63], v[52:55], v[124:127], v[60:63]
  v_mfma_f32_16x16x32_bf16 v[64:67], v[124:127], v[124:127], v[64:67]
  v_mfma_f32_16x16x32_bf16 v[60:63], v[56:59], v[128:131], v[60:63]
  v_mfma_f32_16x16x32_bf16 v[64:67], v[128:131], v[128:131], v[64:67]
  s_waitcnt lgkmcnt(0)
  s_and_b32 s13, s18, 7
  s_lshl_b32 s13, s13, 8
  s_lshr_b32 s14, s18, 3
  s_add_u32 s13, s13, s14
  s_add_u32 s13, s13, 244
  s_cmp_ge_u32 s18, 96
  s_cselect_b32 s13, 0x10000, s13
  s_cmp_gt_i32 s17, 0
  s_cselect_b32 s33, s16, s13
  s_lshl_b32 s22, s33, 12
  v_add_u32 v4, s22, v2
  v_add_u32 v5, s22, v3
  buffer_load_dwordx4 v[116:119], v4, s[4:7], 0 offen offset:0 nt
  buffer_load_dwordx4 v[120:123], v4, s[4:7], 0 offen offset:64 nt
  buffer_load_dwordx4 v[124:127], v4, s[4:7], 0 offen offset:128 nt
  buffer_load_dwordx4 v[128:131], v4, s[4:7], 0 offen offset:192 nt
  s_add_u32 s16, s16, 3
  s_cmp_gt_i32 s17, 1
  s_cbranch_scc1 L_na1
  s_cmp_ge_u32 s33, 2048
  s_cbranch_scc1 L_na1
  s_or_b32 s26, s19, s38
  s_cbranch_scc0 L_na1
  s_mov_b32 s18, 1
  s_atomic_add s18, s[54:55], 0x0 glc
L_na1:
  s_sub_u32 s17, s17, 1
  v_mul_f32 v9, v64, v32
  v_fma_f32 v9, v65, v33, v9
  v_fma_f32 v9, v66, v34, v9
  v_fma_f32 v9, v67, v35, v9
  v_mov_b32 v6, v9
  s_nop 1
  v_permlane32_swap_b32 v9, v6
  v_add_f32 v9, v9, v6
  v_mov_b32 v6, v9
  s_nop 1
  v_permlane16_swap_b32 v9, v6
  v_add_f32 v9, v9, v6
  v_fma_f32 v20, v60, s30, v9
  v_fma_f32 v21, v61, s30, v9
  v_fma_f32 v22, v62, s30, v9
  v_fma_f32 v23, v63, s30, v9
  v_exp_f32 v20, v20
  v_exp_f32 v21, v21
  v_exp_f32 v22, v22
  v_exp_f32 v23, v23
  v_fma_f32 v10, v20, v28, v11
  v_fma_f32 v10, v21, v29, v10
  v_fma_f32 v10, v22, v30, v10
  v_fma_f32 v10, v23, v31, v10
  v_mov_b32 v6, v10
  s_nop 1
  v_permlane16_swap_b32 v10, v6
  v_add_f32 v10, v10, v6
  v_cvt_pk_bf16_f32 v6, v10, v10
  v_and_b32 v6, s31, v6
  v_sub_f32 v6, v10, v6
  v_cvt_pk_bf16_f32 v12, v10, v6
  v_mov_b32 v13, v12
  s_nop 0
  v_mov_b32_dpp v13, v12 row_shl:1 row_mask:0x2 bank_mask:0xf
  v_mov_b32_dpp v13, v12 row_shl:2 row_mask:0x4 bank_mask:0xf
  v_mov_b32_dpp v13, v12 row_shl:3 row_mask:0x8 bank_mask:0xf
  s_nop 1
  v_mov_b32_dpp v24, v13 row_newbcast:0 row_mask:0xf bank_mask:0xf
  v_mov_b32_dpp v25, v13 row_newbcast:4 row_mask:0xf bank_mask:0xf
  v_mov_b32_dpp v26, v13 row_newbcast:8 row_mask:0xf bank_mask:0xf
  v_mov_b32_dpp v27, v13 row_newbcast:12 row_mask:0xf bank_mask:0xf
  v_perm_b32 v76, v24, v24, v36
  v_perm_b32 v77, v24, v24, v37
  v_perm_b32 v78, v24, v24, v38
  v_perm_b32 v79, v24, v24, v39
  v_perm_b32 v80, v25, v25, v36
  v_perm_b32 v81, v25, v25, v37
  v_perm_b32 v82, v25, v25, v38
  v_perm_b32 v83, v25, v25, v39
  s_waitcnt vmcnt(12)
  v_mfma_f32_16x16x32_bf16 v[68:71], v[76:79], v[132:135], v[68:71]
  v_mfma_f32_16x16x32_bf16 v[72:75], v[76:79], v[40:43], v[72:75]
  v_perm_b32 v76, v26, v26, v36
  v_perm_b32 v77, v26, v26, v37
  v_perm_b32 v78, v26, v26, v38
  v_perm_b32 v79, v26, v26, v39
  v_mfma_f32_16x16x32_bf16 v[68:71], v[80:83], v[136:139], v[68:71]
  v_mfma_f32_16x16x32_bf16 v[72:75], v[80:83], v[40:43], v[72:75]
  v_perm_b32 v80, v27, v27, v36
  v_perm_b32 v81, v27, v27, v37
  v_perm_b32 v82, v27, v27, v38
  v_perm_b32 v83, v27, v27, v39
  v_mfma_f32_16x16x32_bf16 v[68:71], v[76:79], v[140:143], v[68:71]
  v_mfma_f32_16x16x32_bf16 v[72:75], v[76:79], v[40:43], v[72:75]
  s_nop 0
  v_mfma_f32_16x16x32_bf16 v[68:71], v[80:83], v[144:147], v[68:71]
  v_mfma_f32_16x16x32_bf16 v[72:75], v[80:83], v[40:43], v[72:75]
  buffer_load_dwordx4 v[132:135], v5, s[8:11], 0 offen offset:0 nt
  buffer_load_dwordx4 v[136:139], v5, s[8:11], 0 offen offset:1024 nt
  buffer_load_dwordx4 v[140:143], v5, s[8:11], 0 offen offset:2048 nt
  buffer_load_dwordx4 v[144:147], v5, s[8:11], 0 offen offset:3072 nt
  s_branch L_loop
L_event:
  s_cmp_eq_u32 s17, 4
  s_cbranch_scc1 L_evload
  s_cmp_eq_u32 s17, 112
  s_cbranch_scc1 L_evset
  s_mov_b32 s26, 0
  s_atomic_swap s26, s[54:55], 0x0 glc
  s_lshl_b32 s12, s27, 13
  v_add_u32 v7, s12, v3
  v_mov_b32 v20, -1
  v_mov_b32 v21, -1
  v_mov_b32 v22, -1
  v_mov_b32 v23, -1
  global_store_dwordx4 v7, v[20:23], s[52:53] offset:1024 sc0 sc1
  global_store_dwordx4 v7, v[20:23], s[52:53] offset:2048 sc0 sc1
  global_store_dwordx4 v7, v[20:23], s[52:53] offset:3072 sc0 sc1
  v_add_u32 v7, 4096, v7
  global_store_dwordx4 v7, v[20:23], s[52:53] offset:0 sc0 sc1
  global_store_dwordx4 v7, v[20:23], s[52:53] offset:1024 sc0 sc1
  global_store_dwordx4 v7, v[20:23], s[52:53] offset:2048 sc0 sc1
  global_store_dwordx4 v7, v[20:23], s[52:53] offset:3072 sc0 sc1
  s_mov_b32 s20, 112
  s_branch L_evret
L_evset:
  s_waitcnt vmcnt(0) lgkmcnt(0)
  s_mov_b32 s26, 1
  s_atomic_add s26, s[24:25], 0x0 glc
  s_mov_b32 s20, 4
  s_branch L_evret
L_evload:
  s_load_dword s19, s[24:25], 0x0
  s_mov_b32 s20, 0x7fffffff
  s_branch L_evret
L_epi:
  s_nop 3
  ds_write_b128 v15, v[68:71]
  ds_write_b32 v16, v72
  s_waitcnt lgkmcnt(0)
  s_barrier
  s_cmp_lg_u32 s3, 0
  s_cbranch_scc1 L_done
  v_mov_b32 v7, 2048
  ds_read_b64 v[44:45], v17 offset:0
  ds_read_b64 v[46:47], v17 offset:512
  ds_read_b64 v[48:49], v17 offset:1024
  ds_read_b64 v[50:51], v17 offset:1536
  ds_read_b128 v[76:79], v7
  s_lshl_b32 s26, s27, 3
  s_add_u32 s26, s26, s15
  s_lshl_b32 s26, s26, 10
  v_add_u32 v7, s26, v3
  s_waitcnt lgkmcnt(0)
  v_pk_add_f32 v[44:45], v[44:45], v[46:47]
  v_pk_add_f32 v[48:49], v[48:49], v[50:51]
  v_pk_add_f32 v[76:77], v[76:77], v[78:79]
  v_pk_add_f32 v[20:21], v[44:45], v[48:49]
  v_add_f32 v22, v76, v77
  s_cmp_eq_u32 s15, 0
  s_cbranch_scc1 L_finish
  s_cmp_lg_u32 s19, 0
  s_cbranch_scc1 L_pub
  s_mov_b32 s12, 0x400000
L_wflag:
  s_load_dword s19, s[24:25], 0x0 glc
  s_sub_u32 s12, s12, 1
  s_waitcnt lgkmcnt(0)
  s_cmp_lg_u32 s19, 0
  s_cbranch_scc1 L_pub
  s_cmp_lg_u32 s12, 0
  s_cbranch_scc1 L_wflag
L_pub:
  v_min_u32 v20, -2, v20
  v_min_u32 v21, -2, v21
  v_min_u32 v22, -2, v22
  v_mov_b32 v23, 0
  global_store_dwordx4 v7, v[20:23], s[52:53] sc0 sc1
  s_branch L_fin
L_finish:
  v_add_u32 v8, 4096, v7
  s_mov_b32 s12, 0x400000
L_poll:
  global_load_dwordx4 v[44:47], v7, s[52:53] offset:1024 sc0 sc1
  global_load_dwordx4 v[48:51], v7, s[52:53] offset:2048 sc0 sc1
  global_load_dwordx4 v[52:55], v7, s[52:53] offset:3072 sc0 sc1
  global_load_dwordx4 v[56:59], v8, s[52:53] offset:0 sc0 sc1
  global_load_dwordx4 v[24:27], v8, s[52:53] offset:1024 sc0 sc1
  global_load_dwordx4 v[76:79], v8, s[52:53] offset:2048 sc0 sc1
  global_load_dwordx4 v[80:83], v8, s[52:53] offset:3072 sc0 sc1
  s_sub_u32 s12, s12, 1
  s_waitcnt vmcnt(0)
  v_max3_u32 v6, v44, v45, v46
  v_max3_u32 v9, v48, v49, v50
  v_max_u32 v6, v6, v9
  v_max3_u32 v9, v52, v53, v54
  v_max_u32 v6, v6, v9
  v_max3_u32 v9, v56, v57, v58
  v_max_u32 v6, v6, v9
  v_max3_u32 v9, v24, v25, v26
  v_max_u32 v6, v6, v9
  v_max3_u32 v9, v76, v77, v78
  v_max_u32 v6, v6, v9
  v_max3_u32 v9, v80, v81, v82
  v_max_u32 v6, v6, v9
  v_cmp_eq_u32 vcc, -1, v6
  s_cmp_eq_u32 s12, 0
  s_cbranch_scc1 L_got
  s_nop 2
  s_cbranch_vccnz L_poll
L_got:
  v_pk_add_f32 v[44:45], v[44:45], v[48:49]
  v_pk_add_f32 v[52:53], v[52:53], v[56:57]
  v_pk_add_f32 v[24:25], v[24:25], v[76:77]
  v_pk_add_f32 v[20:21], v[20:21], v[80:81]
  v_add_f32 v46, v46, v50
  v_add_f32 v54, v54, v58
  v_add_f32 v26, v26, v78
  v_add_f32 v22, v22, v82
  v_pk_add_f32 v[44:45], v[44:45], v[52:53]
  v_pk_add_f32 v[20:21], v[20:21], v[24:25]
  v_add_f32 v46, v46, v54
  v_add_f32 v22, v22, v26
  v_pk_add_f32 v[20:21], v[20:21], v[44:45]
  v_add_f32 v22, v22, v46
  v_add_f32 v22, 0x358637bd, v22
  v_rcp_f32 v22, v22
  v_lshlrev_b32 v6, 2, v1
  v_add_u32 v6, s28, v6
  v_mul_f32 v20, v20, v22
  v_mul_f32 v21, v21, v22
  v_cvt_pk_bf16_f32 v20, v20, v21
  global_store_dword v6, v20, s[48:49] sc0 sc1
L_fin:
L_done:
L_last:
  s_endpgm
.section .rodata,"a"
.p2align 6
.amdhsa_kernel standalone__linear_kernel_rfa__decode_kernel
  .amdhsa_next_free_vgpr 148
  .amdhsa_next_free_sgpr 64
  .amdhsa_accum_offset 148
  .amdhsa_group_segment_fixed_size 0
  .amdhsa_kernarg_size 56
  .amdhsa_user_sgpr_count 2
  .amdhsa_user_sgpr_kernarg_segment_ptr 1
  .amdhsa_system_sgpr_workgroup_id_x 1
.end_amdhsa_kernel
```
